```python
import torch

def _softmax(x, axis=-1):
    return torch.softmax(x, dim=axis)
def _gelu(x):
    return torch.nn.functional.gelu(x, approximate="tanh")
def _silu(x):
    return torch.nn.functional.silu(x)
def _sigmoid(x):
    return torch.sigmoid(x)
def _layernorm(x, axis=-1, eps=1e-5):
    m = x.mean(dim=axis, keepdim=True)
    v = x.var(dim=axis, keepdim=True, unbiased=False)
    return (x - m) / torch.sqrt(v + eps)
def _scatter_add(tgt, idx, src, axis=0):
    return tgt.clone().index_add_(axis, idx, src)
def _segment_sum(src, seg, n):
    out = torch.zeros((n,) + src.shape[1:], dtype=src.dtype)
    return out.index_add_(0, seg, src)
def _pad(x, pw):
    flat = tuple(v for pair in reversed(pw) for v in pair)
    return torch.nn.functional.pad(x, flat)

kernel_name = 'standalone__softmax_full_bidir__sampling'

def setup_inputs():

    _w = (lambda a: (lambda t: t.to(torch.bfloat16) if t.is_floating_point() else t)(torch.as_tensor(a)))
    B, H, Sq, Skv, Dh = 8, 16, 4, 2048, 256
    return {
        "q": _w((lambda *s: torch.randn(*s, dtype=torch.bfloat16) * 0.8)(B, H, Sq, Dh)),
        "k": _w((lambda *s: torch.randn(*s, dtype=torch.bfloat16) * 0.8)(B, H, Skv, Dh)),
        "v": _w((lambda *s: torch.randn(*s, dtype=torch.bfloat16) * 0.05)(B, H, Skv, Dh)),
    }

def reference(q, k, v):
    scale = q.shape[-1] ** -0.5
    scores = torch.einsum('bhqd,bhkd->bhqk', q, k) * scale
    attn = _softmax(scores, axis=-1)
    return torch.einsum('bhqk,bhkd->bhqd', attn, v)
```

```asm
; @launch grid=(256,1,1) block=(256,1,1) lds=42240
.amdgcn_target "amdgcn-amd-amdhsa--gfx950"
.text
.globl standalone__softmax_full_bidir__sampling_kernel
.p2align 8
.type standalone__softmax_full_bidir__sampling_kernel,@function
standalone__softmax_full_bidir__sampling_kernel:
  s_cmp_ge_u32 s2, 256
  s_cbranch_scc1 L_done
  s_load_dwordx8 s[36:43], s[0:1], 0
  s_load_dwordx4 s[44:47], s[0:1], 32
  v_lshrrev_b32 v28, 6, v0
  v_and_b32 v1, 63, v0
  v_readfirstlane_b32 s48, v28
  s_and_b32 s64, s2, 7
  s_lshl_b32 s64, s64, 1
  s_lshr_b32 s65, s2, 5
  s_lshl_b32 s65, s65, 4
  s_or_b32 s64, s64, s65
  s_bfe_u32 s65, s2, 0x10004
  s_or_b32 s49, s64, s65
  s_bfe_u32 s50, s2, 0x10003
  v_lshrrev_b32 v28, 5, v1
  v_and_b32 v29, 31, v1
  v_lshlrev_b32 v30, 2, v28
  v_xor_b32 v29, v29, v30
  v_lshlrev_b32 v28, 9, v28
  v_xor_b32 v30, 0, v29
  v_lshl_add_u32 v2, v30, 4, v28
  v_xor_b32 v30, 1, v29
  v_lshl_add_u32 v3, v30, 4, v28
  v_xor_b32 v30, 2, v29
  v_lshl_add_u32 v4, v30, 4, v28
  v_xor_b32 v30, 3, v29
  v_lshl_add_u32 v5, v30, 4, v28
  s_cmp_eq_u32 s50, 0
  s_cselect_b32 s51, 15, 17
  s_cselect_b32 s64, 0, 32768
  s_cselect_b32 s10, 32, 31
  s_lshl_b32 s66, s49, 20
  s_add_u32 s64, s64, s66
  s_lshl_b32 s10, s10, 15
  s_mov_b32 s11, 0x20000
  s_lshl_b32 s53, s48, 12
  s_add_u32 s54, s53, 16384
  s_mul_i32 s56, s48, 8448
  s_mov_b32 m0, s56
  s_add_u32 s57, s56, 4224
  s_waitcnt lgkmcnt(0)
  s_add_u32 s8, s38, s64
  s_addc_u32 s9, s39, 0
  s_and_b32 s9, s9, 0xffff
  buffer_load_dwordx4 v2, s[8:11], s53 offen offset:0 nt lds
  buffer_load_dwordx4 v3, s[8:11], s53 offen offset:1024 nt lds
  buffer_load_dwordx4 v4, s[8:11], s53 offen offset:2048 nt lds
  buffer_load_dwordx4 v5, s[8:11], s53 offen offset:3072 nt lds
  s_mov_b32 m0, s57
  s_nop 0
  buffer_load_dwordx4 v2, s[8:11], s54 offen offset:0 nt lds
  buffer_load_dwordx4 v3, s[8:11], s54 offen offset:1024 nt lds
  buffer_load_dwordx4 v4, s[8:11], s54 offen offset:2048 nt lds
  buffer_load_dwordx4 v5, s[8:11], s54 offen offset:3072 nt lds
  s_add_u32 s53, s53, 65536
  s_add_u32 s54, s54, 65536
  s_lshl_b32 s66, s49, 11
  s_add_u32 s16, s36, s66
  s_addc_u32 s17, s37, 0
  s_and_b32 s17, s17, 0xffff
  s_mov_b32 s18, 2048
  s_mov_b32 s19, 0x20000
  s_mul_i32 s66, s48, 2048
  s_add_u32 s66, s66, 34048
  s_mov_b32 m0, s66
  v_lshlrev_b32 v6, 4, v1
  buffer_load_dwordx4 v6, s[16:19], 0 offen lds
  buffer_load_dwordx4 v6, s[16:19], 0 offen offset:1024 lds
  s_add_u32 s12, s40, s64
  s_addc_u32 s13, s41, 0
  s_and_b32 s13, s13, 0xffff
  s_mov_b32 s14, s10
  s_mov_b32 s15, 0x20000
  s_lshl_b32 s55, s48, 12
  s_add_u32 s63, s55, 16384
  v_and_b32 v28, 3, v1
  v_lshrrev_b32 v29, 4, v1
  v_lshlrev_b32 v30, 9, v28
  v_lshl_add_u32 v30, v29, 4, v30
  v_add_u32 v202, s66, v30
  v_xor_b32 v29, v29, v28
  v_lshlrev_b32 v29, 4, v29
  v_lshl_add_u32 v29, v28, 10, v29
  v_bfe_u32 v30, v1, 2, 1
  v_mul_u32_u24 v30, 4224, v30
  v_add_u32 v29, v29, v30
  v_bfe_u32 v30, v1, 3, 1
  v_lshl_add_u32 v29, v30, 9, v29
  v_add_u32 v29, s56, v29
  v_lshlrev_b32 v30, 6, v30
  v_add_u32 v7, v29, v30
  v_sub_u32 v8, v29, v30
  v_mov_b32 v9, 0xff800000
  v_mov_b32 v10, 0
  v_mov_b32 v64, 0
  v_mov_b32 v65, 0
  v_mov_b32 v66, 0
  v_mov_b32 v67, 0
  v_mov_b32 v68, 0
  v_mov_b32 v69, 0
  v_mov_b32 v70, 0
  v_mov_b32 v71, 0
  v_mov_b32 v72, 0
  v_mov_b32 v73, 0
  v_mov_b32 v74, 0
  v_mov_b32 v75, 0
  v_mov_b32 v76, 0
  v_mov_b32 v77, 0
  v_mov_b32 v78, 0
  v_mov_b32 v79, 0
  v_mov_b32 v80, 0
  v_mov_b32 v81, 0
  v_mov_b32 v82, 0
  v_mov_b32 v83, 0
  v_mov_b32 v84, 0
  v_mov_b32 v85, 0
  v_mov_b32 v86, 0
  v_mov_b32 v87, 0
  v_mov_b32 v88, 0
  v_mov_b32 v89, 0
  v_mov_b32 v90, 0
  v_mov_b32 v91, 0
  v_mov_b32 v92, 0
  v_mov_b32 v93, 0
  v_mov_b32 v94, 0
  v_mov_b32 v95, 0
  s_mov_b32 s60, 0x3db8aa3b
  s_mov_b32 s61, 0x05040100
  s_mov_b32 s62, 0x07060302
  s_mov_b32 s20, s42
  s_and_b32 s21, s43, 0xffff
  s_mov_b32 s22, 262144
  s_mov_b32 s23, 0x20000
  s_mov_b32 s28, s44
  s_and_b32 s29, s45, 0xffff
  s_mov_b32 s30, 256
  s_mov_b32 s31, 0x20000
  s_mov_b32 s24, s46
  s_and_b32 s25, s47, 0xffff
  s_mov_b32 s26, 2097152
  s_mov_b32 s27, 0x20000
  s_lshr_b32 s64, s49, 1
  s_lshl_b32 s64, s64, 2
  v_mov_b32 v198, s64
  s_and_b32 s71, s49, 1
  s_lshl_b32 s71, s71, 4
  s_lshl_b32 s64, s49, 1
  s_add_u32 s69, s64, s50
  s_xor_b32 s70, s69, 1
  s_lshl_b32 s69, s69, 13
  s_lshl_b32 s70, s70, 13
  s_add_u32 s64, s69, 4160
  v_mov_b32 v205, s64
  s_add_u32 s64, s70, 4160
  v_mov_b32 v204, s64
  v_lshlrev_b32 v199, 4, v0
  s_lshl_b32 s64, s48, 3
  s_add_u32 s64, s64, 4096
  v_mov_b32 v201, s64
  s_cmp_eq_u32 s50, 0
  s_cselect_b32 s64, 2, 4
  s_sub_u32 s75, s51, s64
  s_cmp_eq_u32 s50, 0
  s_cselect_b32 s35, 0xffff, 14
  s_mov_b32 s4, 32768
  s_mov_b32 s5, 65536
  v_and_b32 v28, 31, v1
  v_lshlrev_b32 v28, 5, v28
  v_lshrrev_b32 v29, 5, v1
  v_lshl_add_u32 v28, v29, 4, v28
  v_add_u32 v210, s56, v28
  v_lshlrev_b32 v29, 4, v1
  s_lshl_b32 s64, s48, 10
  v_add_u32 v207, s64, v29
  s_lshl_b32 s64, s48, 4
  s_add_u32 s64, s64, 33920
  v_mov_b32 v208, s64
  v_and_b32 v28, 3, v1
  v_lshlrev_b32 v28, 2, v28
  v_add_u32 v209, 33984, v28
  s_waitcnt vmcnt(6)
  buffer_load_dwordx4 v[160:163], v6, s[12:15], s55 offen offset:0 nt
  s_waitcnt vmcnt(6)
  buffer_load_dwordx4 v[164:167], v6, s[12:15], s55 offen offset:1024 nt
  s_waitcnt vmcnt(6)
  buffer_load_dwordx4 v[168:171], v6, s[12:15], s55 offen offset:2048 nt
  s_waitcnt vmcnt(6)
  buffer_load_dwordx4 v[172:175], v6, s[12:15], s55 offen offset:3072 nt
  s_waitcnt vmcnt(6)
  buffer_load_dwordx4 v[176:179], v6, s[12:15], s63 offen offset:0 nt
  s_waitcnt vmcnt(6)
  buffer_load_dwordx4 v[180:183], v6, s[12:15], s63 offen offset:1024 nt
  s_waitcnt vmcnt(6)
  buffer_load_dwordx4 v[184:187], v6, s[12:15], s63 offen offset:2048 nt
  ds_read_b128 v[32:35], v202 offset:0
  ds_read_b128 v[36:39], v202 offset:64
  ds_read_b128 v[40:43], v202 offset:128
  ds_read_b128 v[44:47], v202 offset:192
  ds_read_b128 v[48:51], v202 offset:256
  ds_read_b128 v[52:55], v202 offset:320
  ds_read_b128 v[56:59], v202 offset:384
  ds_read_b128 v[60:63], v202 offset:448
  s_waitcnt lgkmcnt(0)
  ds_read_b128 v[96:99], v7 offset:0
  ds_read_b128 v[100:103], v8 offset:64
  ds_read_b128 v[104:107], v7 offset:128
  ds_read_b128 v[108:111], v8 offset:192
  ds_read_b128 v[112:115], v7 offset:256
  ds_read_b128 v[116:119], v8 offset:320
  ds_read_b128 v[120:123], v7 offset:384
  ds_read_b128 v[124:127], v8 offset:448
  s_waitcnt vmcnt(6)
  buffer_load_dwordx4 v[188:191], v6, s[12:15], s63 offen offset:3072 nt
  s_add_u32 s55, s55, 65536
  s_add_u32 s63, s63, 65536
  s_waitcnt lgkmcnt(7)
  v_mfma_f32_16x16x32_bf16 v[12:15], v[96:99], v[32:35], 0
  s_waitcnt lgkmcnt(6)
  v_mfma_f32_16x16x32_bf16 v[12:15], v[100:103], v[36:39], v[12:15]
  s_waitcnt lgkmcnt(5)
  v_mfma_f32_16x16x32_bf16 v[12:15], v[104:107], v[40:43], v[12:15]
  s_waitcnt lgkmcnt(4)
  v_mfma_f32_16x16x32_bf16 v[12:15], v[108:111], v[44:47], v[12:15]
  s_waitcnt lgkmcnt(3)
  v_mfma_f32_16x16x32_bf16 v[12:15], v[112:115], v[48:51], v[12:15]
  s_waitcnt lgkmcnt(2)
  v_mfma_f32_16x16x32_bf16 v[12:15], v[116:119], v[52:55], v[12:15]
  s_waitcnt lgkmcnt(1)
  v_mfma_f32_16x16x32_bf16 v[12:15], v[120:123], v[56:59], v[12:15]
  s_waitcnt lgkmcnt(0)
  v_mfma_f32_16x16x32_bf16 v[12:15], v[124:127], v[60:63], v[12:15]
  s_mov_b32 s52, 1
  buffer_load_dword v203, v204, s[24:27], 0 offen sc1
  buffer_load_dword v206, v205, s[24:27], 0 offen sc1
L_loop:
  s_cmp_ge_u32 s52, s75
  s_cbranch_scc1 L_loop2
  s_mov_b32 m0, s56
  s_waitcnt vmcnt(4)
  buffer_load_dwordx4 v2, s[8:11], s53 offen offset:0 nt lds
  s_nop 4
  v_max3_f32 v28, v12, v13, v14
  v_max_f32 v28, v28, v15
  v_mov_b32 v29, v28
  s_nop 1
  v_permlane16_swap_b32 v28, v29
  v_max_f32 v28, v28, v29
  v_max_f32 v28, v28, v9
  v_sub_f32 v29, v9, v28
  v_mul_f32 v30, s60, v28
  v_mul_f32 v29, s60, v29
  v_mov_b32 v9, v28
  v_exp_f32 v29, v29
  v_fma_f32 v16, v12, s60, -v30
  s_waitcnt vmcnt(4)
  buffer_load_dwordx4 v3, s[8:11], s53 offen offset:1024 nt lds
  v_fma_f32 v17, v13, s60, -v30
  v_fma_f32 v18, v14, s60, -v30
  v_fma_f32 v19, v15, s60, -v30
  v_exp_f32 v16, v16
  v_exp_f32 v17, v17
  v_exp_f32 v18, v18
  v_exp_f32 v19, v19
  v_mov_b32_dpp v24, v29 quad_perm:[0,0,0,0] row_mask:0xf bank_mask:0xf
  v_mov_b32_dpp v25, v29 quad_perm:[1,1,1,1] row_mask:0xf bank_mask:0xf
  v_mov_b32_dpp v26, v29 quad_perm:[2,2,2,2] row_mask:0xf bank_mask:0xf
  v_mov_b32_dpp v27, v29 quad_perm:[3,3,3,3] row_mask:0xf bank_mask:0xf
  v_cvt_pk_bf16_f32 v20, v16, v17
  v_cvt_pk_bf16_f32 v21, v18, v19
  s_waitcnt vmcnt(4)
  buffer_load_dwordx4 v4, s[8:11], s53 offen offset:2048 nt lds
  v_add_f32 v30, v16, v17
  v_mov_b32 v22, v20
  v_mov_b32 v23, v21
  v_add_f32 v31, v18, v19
  v_fma_f32 v10, v10, v29, v30
  v_permlane16_swap_b32 v20, v22
  v_permlane16_swap_b32 v21, v23
  v_add_f32 v10, v10, v31
  v_pk_mul_f32 v[64:65], v[64:65], v[24:25]
  v_pk_mul_f32 v[66:67], v[66:67], v[26:27]
  v_pk_mul_f32 v[68:69], v[68:69], v[24:25]
  v_pk_mul_f32 v[70:71], v[70:71], v[26:27]
  s_waitcnt vmcnt(4)
  buffer_load_dwordx4 v5, s[8:11], s53 offen offset:3072 nt lds
  v_pk_mul_f32 v[72:73], v[72:73], v[24:25]
  v_pk_mul_f32 v[74:75], v[74:75], v[26:27]
  v_pk_mul_f32 v[76:77], v[76:77], v[24:25]
  v_pk_mul_f32 v[78:79], v[78:79], v[26:27]
  v_pk_mul_f32 v[80:81], v[80:81], v[24:25]
  v_pk_mul_f32 v[82:83], v[82:83], v[26:27]
  v_pk_mul_f32 v[84:85], v[84:85], v[24:25]
  v_pk_mul_f32 v[86:87], v[86:87], v[26:27]
  v_pk_mul_f32 v[88:89], v[88:89], v[24:25]
  v_pk_mul_f32 v[90:91], v[90:91], v[26:27]
  v_pk_mul_f32 v[92:93], v[92:93], v[24:25]
  v_pk_mul_f32 v[94:95], v[94:95], v[26:27]
  s_mov_b32 m0, s57
  s_waitcnt vmcnt(4)
  buffer_load_dwordx4 v2, s[8:11], s54 offen offset:0 nt lds
  v_perm_b32 v128, v164, v160, s61
  v_perm_b32 v130, v164, v160, s62
  v_perm_b32 v132, v165, v161, s61
  v_perm_b32 v134, v165, v161, s62
  s_waitcnt vmcnt(4)
  buffer_load_dwordx4 v3, s[8:11], s54 offen offset:1024 nt lds
  v_perm_b32 v136, v166, v162, s61
  v_perm_b32 v138, v166, v162, s62
  v_perm_b32 v140, v167, v163, s61
  v_perm_b32 v142, v167, v163, s62
  v_perm_b32 v129, v172, v168, s61
  v_perm_b32 v131, v172, v168, s62
  s_waitcnt vmcnt(4)
  buffer_load_dwordx4 v4, s[8:11], s54 offen offset:2048 nt lds
  s_waitcnt vmcnt(4)
  buffer_load_dwordx4 v5, s[8:11], s54 offen offset:3072 nt lds
  s_add_u32 s53, s53, 65536
  s_add_u32 s54, s54, 65536
  v_perm_b32 v133, v173, v169, s61
  v_perm_b32 v135, v173, v169, s62
  v_perm_b32 v137, v174, v170, s61
  v_perm_b32 v139, v174, v170, s62
  v_perm_b32 v141, v175, v171, s61
  v_perm_b32 v143, v175, v171, s62
  s_waitcnt vmcnt(4)
  buffer_load_dwordx4 v[160:163], v6, s[12:15], s55 offen offset:0 nt
  v_perm_b32 v144, v180, v176, s61
  v_perm_b32 v146, v180, v176, s62
  v_perm_b32 v148, v181, v177, s61
  v_perm_b32 v150, v181, v177, s62
  s_waitcnt vmcnt(4)
  buffer_load_dwordx4 v[164:167], v6, s[12:15], s55 offen offset:1024 nt
  v_perm_b32 v152, v182, v178, s61
  v_perm_b32 v154, v182, v178, s62
  v_perm_b32 v156, v183, v179, s61
  v_perm_b32 v158, v183, v179, s62
  s_waitcnt vmcnt(4)
  buffer_load_dwordx4 v[168:171], v6, s[12:15], s55 offen offset:2048 nt
  v_perm_b32 v145, v188, v184, s61
  v_perm_b32 v147, v188, v184, s62
  v_perm_b32 v149, v189, v185, s61
  v_perm_b32 v151, v189, v185, s62
  s_waitcnt vmcnt(4)
  buffer_load_dwordx4 v[172:175], v6, s[12:15], s55 offen offset:3072 nt
  v_perm_b32 v153, v190, v186, s61
  v_perm_b32 v155, v190, v186, s62
  v_perm_b32 v157, v191, v187, s61
  v_perm_b32 v159, v191, v187, s62
  s_waitcnt vmcnt(4)
  buffer_load_dwordx4 v[176:179], v6, s[12:15], s63 offen offset:0 nt
  v_mfma_f32_4x4x4_16b_bf16 v[64:67], v[20:21], v[128:129], v[64:67]
  v_mfma_f32_4x4x4_16b_bf16 v[68:71], v[20:21], v[130:131], v[68:71]
  v_mfma_f32_4x4x4_16b_bf16 v[72:75], v[20:21], v[132:133], v[72:75]
  v_mfma_f32_4x4x4_16b_bf16 v[76:79], v[20:21], v[134:135], v[76:79]
  v_mfma_f32_4x4x4_16b_bf16 v[80:83], v[20:21], v[136:137], v[80:83]
  v_mfma_f32_4x4x4_16b_bf16 v[84:87], v[20:21], v[138:139], v[84:87]
  v_mfma_f32_4x4x4_16b_bf16 v[88:91], v[20:21], v[140:141], v[88:91]
  v_mfma_f32_4x4x4_16b_bf16 v[92:95], v[20:21], v[142:143], v[92:95]
  s_waitcnt vmcnt(4)
  buffer_load_dwordx4 v[180:183], v6, s[12:15], s63 offen offset:1024 nt
  v_mfma_f32_4x4x4_16b_bf16 v[64:67], v[22:23], v[144:145], v[64:67]
  v_mfma_f32_4x4x4_16b_bf16 v[68:71], v[22:23], v[146:147], v[68:71]
  v_mfma_f32_4x4x4_16b_bf16 v[72:75], v[22:23], v[148:149], v[72:75]
  v_mfma_f32_4x4x4_16b_bf16 v[76:79], v[22:23], v[150:151], v[76:79]
  v_mfma_f32_4x4x4_16b_bf16 v[80:83], v[22:23], v[152:153], v[80:83]
  v_mfma_f32_4x4x4_16b_bf16 v[84:87], v[22:23], v[154:155], v[84:87]
  v_mfma_f32_4x4x4_16b_bf16 v[88:91], v[22:23], v[156:157], v[88:91]
  v_mfma_f32_4x4x4_16b_bf16 v[92:95], v[22:23], v[158:159], v[92:95]
  ds_read_b128 v[96:99], v7 offset:0
  ds_read_b128 v[100:103], v8 offset:64
  ds_read_b128 v[104:107], v7 offset:128
  ds_read_b128 v[108:111], v8 offset:192
  ds_read_b128 v[112:115], v7 offset:256
  ds_read_b128 v[116:119], v8 offset:320
  ds_read_b128 v[120:123], v7 offset:384
  ds_read_b128 v[124:127], v8 offset:448
  s_waitcnt vmcnt(4)
  buffer_load_dwordx4 v[184:187], v6, s[12:15], s63 offen offset:2048 nt
  s_waitcnt vmcnt(4)
  buffer_load_dwordx4 v[188:191], v6, s[12:15], s63 offen offset:3072 nt
  s_add_u32 s55, s55, 65536
  s_add_u32 s63, s63, 65536
  s_waitcnt lgkmcnt(7)
  v_mfma_f32_16x16x32_bf16 v[12:15], v[96:99], v[32:35], 0
  s_waitcnt lgkmcnt(6)
  v_mfma_f32_16x16x32_bf16 v[12:15], v[100:103], v[36:39], v[12:15]
  s_waitcnt lgkmcnt(5)
  v_mfma_f32_16x16x32_bf16 v[12:15], v[104:107], v[40:43], v[12:15]
  s_waitcnt lgkmcnt(4)
  v_mfma_f32_16x16x32_bf16 v[12:15], v[108:111], v[44:47], v[12:15]
  s_waitcnt lgkmcnt(3)
  v_mfma_f32_16x16x32_bf16 v[12:15], v[112:115], v[48:51], v[12:15]
  s_waitcnt lgkmcnt(2)
  v_mfma_f32_16x16x32_bf16 v[12:15], v[116:119], v[52:55], v[12:15]
  s_waitcnt lgkmcnt(1)
  v_mfma_f32_16x16x32_bf16 v[12:15], v[120:123], v[56:59], v[12:15]
  s_waitcnt lgkmcnt(0)
  v_mfma_f32_16x16x32_bf16 v[12:15], v[124:127], v[60:63], v[12:15]
  s_add_u32 s52, s52, 1
  s_branch L_loop
L_loop2:
  s_cmp_ge_u32 s52, s51
  s_cbranch_scc1 L_last
  s_cmp_ge_u32 s52, s35
  s_cselect_b32 s34, s4, s5
  s_mov_b32 m0, s56
  s_waitcnt vmcnt(7)
  buffer_load_dwordx4 v2, s[8:11], s53 offen offset:0 nt lds
  s_nop 4
  v_max3_f32 v28, v12, v13, v14
  v_max_f32 v28, v28, v15
  v_mov_b32 v29, v28
  s_nop 1
  v_permlane16_swap_b32 v28, v29
  v_max_f32 v28, v28, v29
  v_max_f32 v28, v28, v9
  v_sub_f32 v29, v9, v28
  s_waitcnt vmcnt(7)
  buffer_load_dwordx4 v3, s[8:11], s53 offen offset:1024 nt lds
  v_mul_f32 v30, s60, v28
  v_mul_f32 v29, s60, v29
  v_mov_b32 v9, v28
  v_exp_f32 v29, v29
  v_fma_f32 v16, v12, s60, -v30
  v_fma_f32 v17, v13, s60, -v30
  v_fma_f32 v18, v14, s60, -v30
  s_waitcnt vmcnt(7)
  buffer_load_dwordx4 v4, s[8:11], s53 offen offset:2048 nt lds
  v_fma_f32 v19, v15, s60, -v30
  v_exp_f32 v16, v16
  v_exp_f32 v17, v17
  v_exp_f32 v18, v18
  v_exp_f32 v19, v19
  v_mov_b32_dpp v24, v29 quad_perm:[0,0,0,0] row_mask:0xf bank_mask:0xf
  v_mov_b32_dpp v25, v29 quad_perm:[1,1,1,1] row_mask:0xf bank_mask:0xf
  s_waitcnt vmcnt(7)
  buffer_load_dwordx4 v5, s[8:11], s53 offen offset:3072 nt lds
  v_mov_b32_dpp v26, v29 quad_perm:[2,2,2,2] row_mask:0xf bank_mask:0xf
  v_mov_b32_dpp v27, v29 quad_perm:[3,3,3,3] row_mask:0xf bank_mask:0xf
  v_cvt_pk_bf16_f32 v20, v16, v17
  v_cvt_pk_bf16_f32 v21, v18, v19
  v_add_f32 v30, v16, v17
  v_mov_b32 v22, v20
  v_mov_b32 v23, v21
  s_mov_b32 m0, s57
  s_waitcnt vmcnt(7)
  buffer_load_dwordx4 v2, s[8:11], s54 offen offset:0 nt lds
  v_add_f32 v31, v18, v19
  v_fma_f32 v10, v10, v29, v30
  v_permlane16_swap_b32 v20, v22
  v_permlane16_swap_b32 v21, v23
  v_add_f32 v10, v10, v31
  v_pk_mul_f32 v[64:65], v[64:65], v[24:25]
  v_pk_mul_f32 v[66:67], v[66:67], v[26:27]
  s_waitcnt vmcnt(7)
  buffer_load_dwordx4 v3, s[8:11], s54 offen offset:1024 nt lds
  v_pk_mul_f32 v[68:69], v[68:69], v[24:25]
  v_pk_mul_f32 v[70:71], v[70:71], v[26:27]
  v_pk_mul_f32 v[72:73], v[72:73], v[24:25]
  v_pk_mul_f32 v[74:75], v[74:75], v[26:27]
  v_pk_mul_f32 v[76:77], v[76:77], v[24:25]
  v_pk_mul_f32 v[78:79], v[78:79], v[26:27]
  v_pk_mul_f32 v[80:81], v[80:81], v[24:25]
  s_waitcnt vmcnt(7)
  buffer_load_dwordx4 v4, s[8:11], s54 offen offset:2048 nt lds
  v_pk_mul_f32 v[82:83], v[82:83], v[26:27]
  v_pk_mul_f32 v[84:85], v[84:85], v[24:25]
  v_pk_mul_f32 v[86:87], v[86:87], v[26:27]
  v_pk_mul_f32 v[88:89], v[88:89], v[24:25]
  v_pk_mul_f32 v[90:91], v[90:91], v[26:27]
  v_pk_mul_f32 v[92:93], v[92:93], v[24:25]
  v_pk_mul_f32 v[94:95], v[94:95], v[26:27]
  s_waitcnt vmcnt(7)
  buffer_load_dwordx4 v5, s[8:11], s54 offen offset:3072 nt lds
  s_add_u32 s53, s53, s34
  s_add_u32 s54, s54, s34
  v_perm_b32 v128, v164, v160, s61
  v_perm_b32 v130, v164, v160, s62
  v_perm_b32 v132, v165, v161, s61
  v_perm_b32 v134, v165, v161, s62
  v_perm_b32 v136, v166, v162, s61
  v_perm_b32 v138, v166, v162, s62
  v_perm_b32 v140, v167, v163, s61
  v_perm_b32 v142, v167, v163, s62
  v_perm_b32 v129, v172, v168, s61
  v_perm_b32 v131, v172, v168, s62
  v_perm_b32 v133, v173, v169, s61
  v_perm_b32 v135, v173, v169, s62
  v_perm_b32 v137, v174, v170, s61
  v_perm_b32 v139, v174, v170, s62
  v_perm_b32 v141, v175, v171, s61
  v_perm_b32 v143, v175, v171, s62
  s_waitcnt vmcnt(7)
  buffer_load_dwordx4 v[160:163], v6, s[12:15], s55 offen offset:0 nt
  v_perm_b32 v144, v180, v176, s61
  v_perm_b32 v146, v180, v176, s62
  v_perm_b32 v148, v181, v177, s61
  v_perm_b32 v150, v181, v177, s62
  s_waitcnt vmcnt(7)
  buffer_load_dwordx4 v[164:167], v6, s[12:15], s55 offen offset:1024 nt
  v_perm_b32 v152, v182, v178, s61
  v_perm_b32 v154, v182, v178, s62
  v_perm_b32 v156, v183, v179, s61
  v_perm_b32 v158, v183, v179, s62
  s_waitcnt vmcnt(7)
  buffer_load_dwordx4 v[168:171], v6, s[12:15], s55 offen offset:2048 nt
  v_perm_b32 v145, v188, v184, s61
  v_perm_b32 v147, v188, v184, s62
  v_perm_b32 v149, v189, v185, s61
  v_perm_b32 v151, v189, v185, s62
  s_waitcnt vmcnt(7)
  buffer_load_dwordx4 v[172:175], v6, s[12:15], s55 offen offset:3072 nt
  v_perm_b32 v153, v190, v186, s61
  v_perm_b32 v155, v190, v186, s62
  v_perm_b32 v157, v191, v187, s61
  v_perm_b32 v159, v191, v187, s62
  s_waitcnt vmcnt(7)
  buffer_load_dwordx4 v[176:179], v6, s[12:15], s63 offen offset:0 nt
  v_mfma_f32_4x4x4_16b_bf16 v[64:67], v[20:21], v[128:129], v[64:67]
  v_mfma_f32_4x4x4_16b_bf16 v[68:71], v[20:21], v[130:131], v[68:71]
  v_mfma_f32_4x4x4_16b_bf16 v[72:75], v[20:21], v[132:133], v[72:75]
  v_mfma_f32_4x4x4_16b_bf16 v[76:79], v[20:21], v[134:135], v[76:79]
  v_mfma_f32_4x4x4_16b_bf16 v[80:83], v[20:21], v[136:137], v[80:83]
  v_mfma_f32_4x4x4_16b_bf16 v[84:87], v[20:21], v[138:139], v[84:87]
  v_mfma_f32_4x4x4_16b_bf16 v[88:91], v[20:21], v[140:141], v[88:91]
  v_mfma_f32_4x4x4_16b_bf16 v[92:95], v[20:21], v[142:143], v[92:95]
  s_waitcnt vmcnt(7)
  buffer_load_dwordx4 v[180:183], v6, s[12:15], s63 offen offset:1024 nt
  v_mfma_f32_4x4x4_16b_bf16 v[64:67], v[22:23], v[144:145], v[64:67]
  v_mfma_f32_4x4x4_16b_bf16 v[68:71], v[22:23], v[146:147], v[68:71]
  v_mfma_f32_4x4x4_16b_bf16 v[72:75], v[22:23], v[148:149], v[72:75]
  v_mfma_f32_4x4x4_16b_bf16 v[76:79], v[22:23], v[150:151], v[76:79]
  v_mfma_f32_4x4x4_16b_bf16 v[80:83], v[22:23], v[152:153], v[80:83]
  v_mfma_f32_4x4x4_16b_bf16 v[84:87], v[22:23], v[154:155], v[84:87]
  v_mfma_f32_4x4x4_16b_bf16 v[88:91], v[22:23], v[156:157], v[88:91]
  v_mfma_f32_4x4x4_16b_bf16 v[92:95], v[22:23], v[158:159], v[92:95]
  s_waitcnt vmcnt(7)
  buffer_load_dwordx4 v[184:187], v6, s[12:15], s63 offen offset:2048 nt
  s_waitcnt vmcnt(7)
  buffer_load_dwordx4 v[188:191], v6, s[12:15], s63 offen offset:3072 nt
  s_add_u32 s55, s55, s34
  s_add_u32 s63, s63, s34
  ds_read_b128 v[96:99], v7 offset:0
  ds_read_b128 v[100:103], v8 offset:64
  ds_read_b128 v[104:107], v7 offset:128
  ds_read_b128 v[108:111], v8 offset:192
  ds_read_b128 v[112:115], v7 offset:256
  ds_read_b128 v[116:119], v8 offset:320
  ds_read_b128 v[120:123], v7 offset:384
  ds_read_b128 v[124:127], v8 offset:448
  s_waitcnt lgkmcnt(7)
  v_mfma_f32_16x16x32_bf16 v[12:15], v[96:99], v[32:35], 0
  s_waitcnt lgkmcnt(6)
  v_mfma_f32_16x16x32_bf16 v[12:15], v[100:103], v[36:39], v[12:15]
  s_waitcnt lgkmcnt(5)
  v_mfma_f32_16x16x32_bf16 v[12:15], v[104:107], v[40:43], v[12:15]
  s_waitcnt lgkmcnt(4)
  v_mfma_f32_16x16x32_bf16 v[12:15], v[108:111], v[44:47], v[12:15]
  s_waitcnt lgkmcnt(3)
  v_mfma_f32_16x16x32_bf16 v[12:15], v[112:115], v[48:51], v[12:15]
  s_waitcnt lgkmcnt(2)
  v_mfma_f32_16x16x32_bf16 v[12:15], v[116:119], v[52:55], v[12:15]
  s_waitcnt lgkmcnt(1)
  v_mfma_f32_16x16x32_bf16 v[12:15], v[120:123], v[56:59], v[12:15]
  s_waitcnt lgkmcnt(0)
  v_mfma_f32_16x16x32_bf16 v[12:15], v[124:127], v[60:63], v[12:15]
  s_add_u32 s52, s52, 1
  s_branch L_loop2
L_last:
  s_nop 7
  v_max3_f32 v28, v12, v13, v14
  v_max_f32 v28, v28, v15
  v_mov_b32 v29, v28
  s_nop 1
  v_permlane16_swap_b32 v28, v29
  v_max_f32 v28, v28, v29
  v_max_f32 v28, v28, v9
  v_lshrrev_b32 v29, 5, v1
  v_and_b32 v30, 3, v1
  v_lshlrev_b32 v30, 2, v30
  v_lshl_add_u32 v29, v29, 4, v30
  s_lshl_b32 s64, s48, 5
  s_add_u32 s64, s64, 33792
  v_add_u32 v29, s64, v29
  ds_write_b32 v29, v28
  v_and_b32 v30, 31, v1
  v_lshlrev_b32 v30, 2, v30
  v_add_u32 v30, 33792, v30
  s_waitcnt lgkmcnt(0)
  s_barrier
  ds_read_b32 v28, v30
  buffer_load_dword v11, v204, s[24:27], 0 offen sc1
  s_waitcnt lgkmcnt(0)
  v_max_f32_dpp v29, v28, v28 row_ror:4 row_mask:0xf bank_mask:0xf
  s_nop 1
  v_max_f32_dpp v28, v29, v29 row_ror:8 row_mask:0xf bank_mask:0xf
  v_mov_b32 v29, v28
  s_nop 1
  v_permlane16_swap_b32 v28, v29
  v_max_f32 v28, v28, v29
  v_sub_f32 v29, v9, v28
  v_mul_f32 v30, s60, v28
  v_mul_f32 v29, s60, v29
  v_mov_b32 v9, v28
  v_exp_f32 v29, v29
  v_fma_f32 v16, v12, s60, -v30
  v_fma_f32 v17, v13, s60, -v30
  v_fma_f32 v18, v14, s60, -v30
  v_fma_f32 v19, v15, s60, -v30
  v_exp_f32 v16, v16
  v_exp_f32 v17, v17
  v_exp_f32 v18, v18
  v_exp_f32 v19, v19
  v_mov_b32_dpp v24, v29 quad_perm:[0,0,0,0] row_mask:0xf bank_mask:0xf
  v_mov_b32_dpp v25, v29 quad_perm:[1,1,1,1] row_mask:0xf bank_mask:0xf
  v_mov_b32_dpp v26, v29 quad_perm:[2,2,2,2] row_mask:0xf bank_mask:0xf
  v_mov_b32_dpp v27, v29 quad_perm:[3,3,3,3] row_mask:0xf bank_mask:0xf
  v_cvt_pk_bf16_f32 v20, v16, v17
  v_cvt_pk_bf16_f32 v21, v18, v19
  v_add_f32 v30, v16, v17
  v_mov_b32 v22, v20
  v_mov_b32 v23, v21
  v_add_f32 v31, v18, v19
  v_fma_f32 v10, v10, v29, v30
  v_permlane16_swap_b32 v20, v22
  v_permlane16_swap_b32 v21, v23
  v_add_f32 v10, v10, v31
  v_pk_mul_f32 v[64:65], v[64:65], v[24:25]
  v_pk_mul_f32 v[66:67], v[66:67], v[26:27]
  v_pk_mul_f32 v[68:69], v[68:69], v[24:25]
  v_pk_mul_f32 v[70:71], v[70:71], v[26:27]
  v_pk_mul_f32 v[72:73], v[72:73], v[24:25]
  v_pk_mul_f32 v[74:75], v[74:75], v[26:27]
  v_pk_mul_f32 v[76:77], v[76:77], v[24:25]
  v_pk_mul_f32 v[78:79], v[78:79], v[26:27]
  v_pk_mul_f32 v[80:81], v[80:81], v[24:25]
  v_pk_mul_f32 v[82:83], v[82:83], v[26:27]
  v_pk_mul_f32 v[84:85], v[84:85], v[24:25]
  v_pk_mul_f32 v[86:87], v[86:87], v[26:27]
  v_pk_mul_f32 v[88:89], v[88:89], v[24:25]
  v_pk_mul_f32 v[90:91], v[90:91], v[26:27]
  v_pk_mul_f32 v[92:93], v[92:93], v[24:25]
  v_pk_mul_f32 v[94:95], v[94:95], v[26:27]
  v_mov_b32 v29, v10
  s_nop 1
  v_permlane16_swap_b32 v10, v29
  v_add_f32 v10, v10, v29
  v_mov_b32 v29, v10
  s_nop 1
  v_permlane32_swap_b32 v10, v29
  v_add_f32 v10, v10, v29
  v_and_b32 v30, 3, v1
  v_lshlrev_b32 v30, 4, v30
  s_lshl_b32 s64, s48, 2
  s_add_u32 s64, s64, 33920
  v_add_u32 v30, s64, v30
  ds_write_b32 v30, v10
  v_readlane_b32 s67, v9, s48
  s_lshl_b32 s64, s48, 2
  s_add_u32 s64, s64, 33984
  v_mov_b32 v31, s64
  s_waitcnt vmcnt(5)
  v_perm_b32 v128, v164, v160, s61
  v_perm_b32 v130, v164, v160, s62
  v_perm_b32 v132, v165, v161, s61
  v_perm_b32 v134, v165, v161, s62
  v_perm_b32 v136, v166, v162, s61
  v_perm_b32 v138, v166, v162, s62
  v_perm_b32 v140, v167, v163, s61
  v_perm_b32 v142, v167, v163, s62
  v_perm_b32 v129, v172, v168, s61
  v_perm_b32 v131, v172, v168, s62
  v_perm_b32 v133, v173, v169, s61
  v_perm_b32 v135, v173, v169, s62
  v_perm_b32 v137, v174, v170, s61
  v_perm_b32 v139, v174, v170, s62
  v_perm_b32 v141, v175, v171, s61
  v_perm_b32 v143, v175, v171, s62
  s_nop 1
  v_mfma_f32_4x4x4_16b_bf16 v[64:67], v[20:21], v[128:129], v[64:67]
  v_mfma_f32_4x4x4_16b_bf16 v[68:71], v[20:21], v[130:131], v[68:71]
  v_mfma_f32_4x4x4_16b_bf16 v[72:75], v[20:21], v[132:133], v[72:75]
  v_mfma_f32_4x4x4_16b_bf16 v[76:79], v[20:21], v[134:135], v[76:79]
  v_mfma_f32_4x4x4_16b_bf16 v[80:83], v[20:21], v[136:137], v[80:83]
  v_mfma_f32_4x4x4_16b_bf16 v[84:87], v[20:21], v[138:139], v[84:87]
  v_mfma_f32_4x4x4_16b_bf16 v[88:91], v[20:21], v[140:141], v[88:91]
  v_mfma_f32_4x4x4_16b_bf16 v[92:95], v[20:21], v[142:143], v[92:95]
  s_waitcnt vmcnt(1)
  v_perm_b32 v144, v180, v176, s61
  v_perm_b32 v146, v180, v176, s62
  v_perm_b32 v148, v181, v177, s61
  v_perm_b32 v150, v181, v177, s62
  v_perm_b32 v152, v182, v178, s61
  v_perm_b32 v154, v182, v178, s62
  v_perm_b32 v156, v183, v179, s61
  v_perm_b32 v158, v183, v179, s62
  v_perm_b32 v145, v188, v184, s61
  v_perm_b32 v147, v188, v184, s62
  v_perm_b32 v149, v189, v185, s61
  v_perm_b32 v151, v189, v185, s62
  v_perm_b32 v153, v190, v186, s61
  v_perm_b32 v155, v190, v186, s62
  v_perm_b32 v157, v191, v187, s61
  v_perm_b32 v159, v191, v187, s62
  s_nop 1
  v_mfma_f32_4x4x4_16b_bf16 v[64:67], v[22:23], v[144:145], v[64:67]
  v_mfma_f32_4x4x4_16b_bf16 v[68:71], v[22:23], v[146:147], v[68:71]
  v_mfma_f32_4x4x4_16b_bf16 v[72:75], v[22:23], v[148:149], v[72:75]
  v_mfma_f32_4x4x4_16b_bf16 v[76:79], v[22:23], v[150:151], v[76:79]
  v_mfma_f32_4x4x4_16b_bf16 v[80:83], v[22:23], v[152:153], v[80:83]
  v_mfma_f32_4x4x4_16b_bf16 v[84:87], v[22:23], v[154:155], v[84:87]
  v_mfma_f32_4x4x4_16b_bf16 v[88:91], v[22:23], v[156:157], v[88:91]
  v_mfma_f32_4x4x4_16b_bf16 v[92:95], v[22:23], v[158:159], v[92:95]
  s_waitcnt vmcnt(0)
  v_sub_u32 v11, v11, v203
  s_nop 0
  v_readfirstlane_b32 s68, v11
  s_nop 3
  s_cmp_eq_u32 s68, 1
  s_cselect_b32 s68, 1, 0
  s_cbranch_scc0 L_nopre
  buffer_load_dwordx4 v[192:195], v199, s[24:27], s70 offen sc1
  buffer_load_dwordx2 v[196:197], v201, s[24:27], s70 offen sc1
L_nopre:
  v_mov_b32 v30, s68
  ds_write_b32 v31, v30
  v_permlane32_swap_b32 v64, v80
  v_permlane32_swap_b32 v68, v84
  v_permlane32_swap_b32 v72, v88
  v_permlane32_swap_b32 v76, v92
  v_permlane32_swap_b32 v65, v81
  v_permlane32_swap_b32 v69, v85
  v_permlane32_swap_b32 v73, v89
  v_permlane32_swap_b32 v77, v93
  v_permlane32_swap_b32 v66, v82
  v_permlane32_swap_b32 v70, v86
  v_permlane32_swap_b32 v74, v90
  v_permlane32_swap_b32 v78, v94
  v_permlane32_swap_b32 v67, v83
  v_permlane32_swap_b32 v71, v87
  v_permlane32_swap_b32 v75, v91
  v_permlane32_swap_b32 v79, v95
  v_add_f32 v160, v64, v80
  v_add_f32 v161, v68, v84
  v_add_f32 v162, v72, v88
  v_add_f32 v163, v76, v92
  ds_write_b128 v210, v[160:163] offset:0
  v_add_f32 v164, v65, v81
  v_add_f32 v165, v69, v85
  v_add_f32 v166, v73, v89
  v_add_f32 v167, v77, v93
  ds_write_b128 v210, v[164:167] offset:1024
  v_add_f32 v168, v66, v82
  v_add_f32 v169, v70, v86
  v_add_f32 v170, v74, v90
  v_add_f32 v171, v78, v94
  ds_write_b128 v210, v[168:171] offset:2048
  v_add_f32 v172, v67, v83
  v_add_f32 v173, v71, v87
  v_add_f32 v174, v75, v91
  v_add_f32 v175, v79, v95
  ds_write_b128 v210, v[172:175] offset:3072
  s_waitcnt lgkmcnt(0)
  s_barrier
  ds_read_b128 v[96:99], v207 offset:0
  ds_read_b128 v[100:103], v207 offset:8448
  ds_read_b128 v[104:107], v207 offset:16896
  ds_read_b128 v[108:111], v207 offset:25344
  ds_read_b128 v[112:115], v208
  ds_read_b32 v116, v209
  s_waitcnt lgkmcnt(2)
  v_pk_add_f32 v[96:97], v[96:97], v[100:101]
  v_pk_add_f32 v[104:105], v[104:105], v[108:109]
  v_pk_add_f32 v[98:99], v[98:99], v[102:103]
  v_pk_add_f32 v[106:107], v[106:107], v[110:111]
  v_pk_add_f32 v[12:13], v[96:97], v[104:105]
  v_pk_add_f32 v[14:15], v[98:99], v[106:107]
  s_waitcnt lgkmcnt(0)
  v_cmp_ne_u32 vcc, 0, v116
  v_pk_add_f32 v[112:113], v[112:113], v[114:115]
  v_mov_b32 v28, s67
  v_add_f32 v29, v112, v113
  s_cmp_eq_u64 vcc, exec
  s_cbranch_scc1 L_combine
  buffer_store_dwordx4 v[12:15], v199, s[24:27], s69 offen sc1
  buffer_store_dwordx2 v[28:29], v201, s[24:27], s69 offen sc1
  s_waitcnt vmcnt(0)
  s_barrier
  s_cmp_lg_u32 s48, 0
  s_cbranch_scc1 L_wait_dec
  s_lshl_b32 s64, 1, s71
  v_mov_b32 v30, s64
  v_cmp_eq_u32 vcc, 0, v1
  v_add_u32 v206, 1, v206
  s_nop 0
  s_and_saveexec_b64 s[72:73], vcc
  buffer_store_dword v206, v205, s[24:27], 0 offen sc1
  buffer_atomic_add v30, v198, s[28:31], 0 offen sc0
  s_waitcnt vmcnt(0)
  v_mov_b32 v31, 34000
  ds_write_b32 v31, v30
  s_mov_b64 exec, s[72:73]
  s_waitcnt lgkmcnt(0)
L_wait_dec:
  s_barrier
  v_mov_b32 v31, 34000
  ds_read_b32 v30, v31
  s_waitcnt lgkmcnt(0)
  v_readfirstlane_b32 s64, v30
  s_nop 3
  s_lshr_b32 s64, s64, s71
  s_and_b32 s64, s64, 0xff
  s_cmp_eq_u32 s64, 0
  s_cbranch_scc1 L_exit
  buffer_load_dwordx4 v[192:195], v199, s[24:27], s70 offen sc1
  buffer_load_dwordx2 v[196:197], v201, s[24:27], s70 offen sc1
L_combine:
  s_waitcnt vmcnt(0)
  v_max_f32 v30, v28, v196
  v_sub_f32 v28, v28, v30
  v_sub_f32 v30, v196, v30
  v_mul_f32 v28, s60, v28
  v_mul_f32 v30, s60, v30
  v_exp_f32 v28, v28
  v_exp_f32 v30, v30
  s_nop 0
  v_mul_f32 v29, v29, v28
  v_fma_f32 v29, v197, v30, v29
  v_rcp_f32 v29, v29
  s_nop 0
  v_mul_f32 v28, v28, v29
  v_mul_f32 v30, v30, v29
  v_mul_f32 v12, v12, v28
  v_mul_f32 v13, v13, v28
  v_mul_f32 v14, v14, v28
  v_mul_f32 v15, v15, v28
  v_fma_f32 v12, v192, v30, v12
  v_fma_f32 v13, v193, v30, v13
  v_fma_f32 v14, v194, v30, v14
  v_fma_f32 v15, v195, v30, v15
  v_cvt_pk_bf16_f32 v12, v12, v13
  v_cvt_pk_bf16_f32 v13, v14, v15
  v_lshlrev_b32 v29, 3, v0
  s_lshl_b32 s64, s49, 11
  buffer_store_dwordx2 v[12:13], v29, s[20:23], s64 offen nt
L_exit:
L_done:
  s_endpgm
.section .rodata,"a"
.p2align 6
.amdhsa_kernel standalone__softmax_full_bidir__sampling_kernel
  .amdhsa_next_free_vgpr 216
  .amdhsa_next_free_sgpr 80
  .amdhsa_accum_offset 216
  .amdhsa_group_segment_fixed_size 0
  .amdhsa_kernarg_size 48
  .amdhsa_user_sgpr_count 2
  .amdhsa_user_sgpr_kernarg_segment_ptr 1
  .amdhsa_system_sgpr_workgroup_id_x 1
  .amdhsa_float_denorm_mode_32 3
.end_amdhsa_kernel
```
